```python
import torch

def _softmax(x, axis=-1):
    return torch.softmax(x, dim=axis)
def _gelu(x):
    return torch.nn.functional.gelu(x, approximate="tanh")
def _silu(x):
    return torch.nn.functional.silu(x)
def _sigmoid(x):
    return torch.sigmoid(x)
def _layernorm(x, axis=-1, eps=1e-5):
    m = x.mean(dim=axis, keepdim=True)
    v = x.var(dim=axis, keepdim=True, unbiased=False)
    return (x - m) / torch.sqrt(v + eps)
def _scatter_add(tgt, idx, src, axis=0):
    return tgt.clone().index_add_(axis, idx, src)
def _segment_sum(src, seg, n):
    out = torch.zeros((n,) + src.shape[1:], dtype=src.dtype)
    return out.index_add_(0, seg, src)
def _pad(x, pw):
    flat = tuple(v for pair in reversed(pw) for v in pair)
    return torch.nn.functional.pad(x, flat)

kernel_name = 'standalone__paged_block_table_kv_pagedattention__sampling'

def setup_inputs():

    _w = (lambda a: (lambda t: t.to(torch.bfloat16) if t.is_floating_point() else t)(torch.as_tensor(a)))
    B, Hq, Hkv, Sq, Skv, D = 16, 32, 8, 16, 4096, 128
    bs = 16
    nbps = max(1, Skv // bs)
    num_phys = B * nbps + 4
    bt = torch.randperm(num_phys)[: B * nbps].reshape(B, nbps).to(torch.int64)
    cl = (nbps * bs - (torch.arange(1, B + 1, dtype=torch.int64) * 2654435761) % max(1, nbps * bs // 2)).to(torch.int64)
    return {
        "q": _w((lambda *s: torch.randn(*s, dtype=torch.bfloat16) * 0.8)(B, Hq, Sq, D)),
        "k_cache": _w((lambda *s: torch.randn(*s, dtype=torch.bfloat16) * 0.8)(num_phys, bs, Hkv, D)),
        "v_cache": _w((lambda *s: torch.randn(*s, dtype=torch.bfloat16) * 0.05)(num_phys, bs, Hkv, D)),
        "block_table": _w(bt),
        "context_lens": _w(cl),
    }

def reference(q, k_cache, v_cache, block_table, context_lens):
    B, Hq, Sq, D = q.shape
    bs = k_cache.shape[1]
    Hkv = k_cache.shape[2]
    nbps = block_table.shape[1]
    Skv = nbps * bs
    bt = block_table.reshape(-1)
    k = (lambda x, *d: x.permute(*d))(k_cache[bt].reshape(B, Skv, Hkv, D), 0, 2, 1, 3)
    v = (lambda x, *d: x.permute(*d))(v_cache[bt].reshape(B, Skv, Hkv, D), 0, 2, 1, 3)
    g = Hq // Hkv
    qg = q.reshape(B, Hkv, g, Sq, D)
    scores = torch.einsum("bhgqd,bhkd->bhgqk", qg, k) * (D ** -0.5)
    pos = torch.arange(Skv)
    msk = pos[None, :] < context_lens[:, None]
    scores = torch.where(msk[:, None, None, None, :], scores, -1e9)
    p = _softmax(scores, axis=-1)
    out = torch.einsum("bhgqk,bhkd->bhgqd", p, v)
    return out.reshape(B, Hq, Sq, D)
```

```asm
; @launch grid=(256,1,1) block=(512,1,1) lds=82432
.amdgcn_target "amdgcn-amd-amdhsa--gfx950"
.text
.globl standalone__paged_block_table_kv_pagedattention__sampling_kernel
.p2align 8
.type standalone__paged_block_table_kv_pagedattention__sampling_kernel,@function
standalone__paged_block_table_kv_pagedattention__sampling_kernel:
    s_cmp_ge_u32 s2, 256
    s_cbranch_scc1 L_end
    s_load_dwordx16 s[36:51], s[0:1], 0
    v_lshrrev_b32 v1, 6, v0
    s_and_b32 s24, s2, 7
    v_readfirstlane_b32 s26, v1
    s_bfe_u32 s25, s2, 0x40003
    s_cmp_lt_u32 s2, 128
    s_cselect_b32 s27, 1, 0
    v_and_b32 v1, 63, v0
    s_cmp_lt_u32 s26, 4
    s_cbranch_scc1 L_consumer
    v_lshrrev_b32 v2, 4, v1
    v_and_b32 v3, 15, v1
    v_lshlrev_b32 v8, 4, v1
    s_lshl_b32 s30, s25, 10
    s_sub_u32 s28, s26, 4
    s_lshl_b32 s33, s28, 10
    s_lshl_b32 s28, s28, 2
    s_lshl_b32 s29, s24, 8
    v_add_u32 v4, s28, v2
    v_xor_b32 v15, v3, v4
    v_lshlrev_b32 v15, 4, v15
    v_lshl_add_u32 v7, v4, 8, v15
    v_lshl_add_u32 v5, v4, 11, v15
    v_add_u32 v5, s29, v5
    v_lshlrev_b32 v9, 2, v3
    v_and_b32 v10, 0x30, v1
    s_lshl_b32 s34, s25, 3
    s_add_u32 s34, s34, s24
    s_lshl_b32 s34, s34, 14
    s_mov_b32 m0, s33
    s_waitcnt lgkmcnt(0)
    s_mov_b32 s16, s42
    s_mov_b32 s17, s43
    s_mov_b32 s18, 0x4000
    s_mov_b32 s19, 0x20000
    buffer_load_dwordx4 v[20:23], v8, s[16:19], s30 offen
    s_mov_b32 s20, s44
    s_mov_b32 s21, s45
    s_mov_b32 s22, 0x40
    s_mov_b32 s23, 0x20000
    buffer_load_dword v24, v9, s[20:23], 0 offen
    buffer_load_dwordx4 v[28:31], v10, s[20:23], 0 offen
    s_mov_b32 s12, s36
    s_mov_b32 s13, s37
    s_mov_b32 s14, 0x200000
    s_mov_b32 s15, 0x20000
    buffer_load_dwordx4 v7, s[12:15], s34 offen lds
    s_add_u32 m0, s33, 4096
    s_add_u32 s34, s34, 4096
    buffer_load_dwordx4 v7, s[12:15], s34 offen lds
    s_add_u32 m0, s33, 8192
    s_add_u32 s34, s34, 4096
    buffer_load_dwordx4 v7, s[12:15], s34 offen lds
    s_add_u32 m0, s33, 12288
    s_add_u32 s34, s34, 4096
    buffer_load_dwordx4 v7, s[12:15], s34 offen lds
    s_mov_b32 s4, s38
    s_mov_b32 s5, s39
    s_mov_b32 s6, 0x8020000
    s_mov_b32 s7, 0x20000
    s_mov_b32 s8, s40
    s_mov_b32 s9, s41
    s_mov_b32 s10, 0x8020000
    s_mov_b32 s11, 0x20000
    v_and_b32 v15, 7, v4
    v_lshlrev_b32 v15, 1, v15
    v_xor_b32 v15, v3, v15
    v_lshlrev_b32 v15, 4, v15
    v_lshl_add_u32 v6, v4, 11, v15
    v_add_u32 v6, s29, v6
    v_sub_u32 v13, 15, v3
    v_lshlrev_b32 v15, 2, v2
    v_sub_u32 v15, 15, v15
    v_lshlrev_b32 v10, 2, v1
    v_mov_b32 v11, 0x8020000
    s_lshr_b32 s84, s38, 8
    s_add_u32 s84, s84, s24
    s_and_b32 s84, s84, 3
    s_cmp_eq_u32 s84, 1
    s_cselect_b32 s84, 1, 0
    s_cselect_b32 s31, 14, 16
    s_add_u32 s33, s33, 16384
    s_mov_b32 s56, 4294967294
    s_cmp_eq_u32 s27, 0
    s_cbranch_scc1 L_p_sched
    s_mov_b32 m0, s33
    s_waitcnt vmcnt(6)
    v_readlane_b32 s34, v20, 0
    v_readlane_b32 s35, v21, 0
    s_lshl_b32 s34, s34, 15
    s_lshl_b32 s35, s35, 15
    buffer_load_dwordx4 v5, s[4:7], s34 offen nt lds
    s_add_u32 m0, s33, 4096
    s_nop 0
    buffer_load_dwordx4 v5, s[4:7], s35 offen nt lds
    s_add_u32 m0, s33, 8192
    s_nop 0
    buffer_load_dwordx4 v6, s[8:11], s34 offen nt lds
    s_add_u32 m0, s33, 12288
    s_nop 0
    buffer_load_dwordx4 v6, s[8:11], s35 offen nt lds
    s_add_u32 s33, s33, 16384
    s_mov_b32 s56, 4294967295
    s_waitcnt vmcnt(8)
    s_branch L_p_sched2
L_p_sched:
    s_waitcnt vmcnt(4)
L_p_sched2:
    v_cmp_gt_i32 vcc, 1, v24
    v_add_u32 v12, -1, v24
    v_min_u32 v12, 0xfff, v12
    v_lshl_or_b32 v13, v12, 4, v13
    s_and_b32 s75, vcc_lo, 0xffff
    v_add_u32 v28, -1, v28
    v_min_u32 v28, 0xfff, v28
    v_lshl_add_u32 v28, v28, 4, v15
    v_add_u32 v29, -1, v29
    v_min_u32 v29, 0xfff, v29
    v_lshl_add_u32 v29, v29, 4, v15
    v_add_u32 v29, -1, v29
    v_add_u32 v30, -1, v30
    v_min_u32 v30, 0xfff, v30
    v_lshl_add_u32 v30, v30, 4, v15
    v_add_u32 v30, -2, v30
    v_add_u32 v31, -1, v31
    v_min_u32 v31, 0xfff, v31
    v_lshl_add_u32 v31, v31, 4, v15
    v_add_u32 v31, -3, v31
    v_cmp_gt_u32 s[76:77], v28, v13
    v_cmp_gt_u32 s[78:79], v29, v13
    v_cmp_gt_u32 s[80:81], v30, v13
    v_cmp_gt_u32 s[82:83], v31, v13
    v_readlane_b32 s61, v12, s25
    v_cndmask_b32 v14, 0, 1, s[76:77]
    v_cndmask_b32 v8, 0, 1, s[78:79]
    v_cndmask_b32 v9, 0, 1, s[80:81]
    v_cndmask_b32 v15, 0, 1, s[82:83]
    v_add3_u32 v14, v14, v8, v9
    v_add_u32 v14, v14, v15
    v_mov_b32 v8, v14
    s_nop 1
    v_permlane32_swap_b32 v14, v8
    s_nop 1
    v_add_u32 v14, v14, v8
    v_mov_b32 v8, v14
    s_nop 1
    v_permlane16_swap_b32 v14, v8
    s_nop 1
    v_add_u32 v14, v14, v8
    s_lshr_b32 s63, s61, 5
    v_readlane_b32 s59, v14, s25
    s_add_u32 s63, s63, 1
    s_sub_u32 s28, 15, s59
    v_cmp_eq_u32 vcc, s28, v14
    s_ff1_i32_b32 s60, vcc_lo
    v_readlane_b32 s62, v12, s60
    s_lshr_b32 s64, s62, 5
    s_add_u32 s64, s64, 1
    s_max_u32 s28, s63, s64
    s_min_u32 s64, s63, s64
    s_mov_b32 s63, s28
    s_add_u32 s66, s63, s64
    s_add_u32 s66, s66, s31
    s_add_u32 s66, s66, 3
    s_lshr_b32 s66, s66, 2
    s_add_u32 s28, s63, s31
    s_mul_i32 s28, s28, 0x5556
    s_lshr_b32 s28, s28, 16
    s_add_u32 s28, s28, 1
    s_cmp_lt_u32 s64, s66
    s_cselect_b32 s66, s28, s66
    s_min_u32 s67, s63, s66
    s_min_u32 s68, s64, s66
    s_sub_u32 s69, s63, s67
    s_sub_u32 s70, s64, s68
    s_cmp_lg_u32 s70, 0
    s_cselect_b32 s28, 2, 2
    s_add_u32 s71, s69, s70
    s_add_u32 s71, s71, s28
    s_lshr_b32 s71, s71, 1
    s_add_u32 s28, s71, 2
    s_cmp_ge_u32 s28, s69
    s_cselect_b32 s71, s69, s71
    s_sub_u32 s72, s69, s71
    s_cmp_lt_u32 s59, 8
    s_cselect_b32 s32, s67, s68
    s_cselect_b32 s73, s71, s70
    s_cselect_b32 s53, 0, s72
    s_cselect_b32 s29, s72, 0
    s_cmp_lg_u32 s73, 0
    s_cselect_b32 s74, 1, 0
    s_cmp_lg_u32 s29, 0
    s_cselect_b32 s29, 2, 0
    s_or_b32 s74, s74, s29
    s_cmp_eq_u32 s27, 0
    s_cselect_b32 s74, 0, s74
    s_cselect_b32 s73, s73, s32
    s_cselect_b32 s53, s53, 0
    s_cselect_b32 s35, s32, 0
    s_cselect_b32 s32, s32, 1
    s_add_u32 s52, s35, s73
    s_mov_b32 s85, s35
    s_cmp_eq_u32 s27, 1
    s_cbranch_scc1 L_p_nf
    s_cmp_eq_u32 s73, 0
    s_cbranch_scc1 L_p_nf
    s_lshr_b32 s28, s32, 1
    s_mov_b32 m0, s33
    v_readlane_b32 s34, v20, s28
    v_readlane_b32 s35, v21, s28
    v_readlane_b32 s29, v22, s28
    v_readlane_b32 s30, v23, s28
    s_bitcmp1_b32 s32, 0
    s_cselect_b32 s34, s29, s34
    s_cselect_b32 s35, s30, s35
    s_lshl_b32 s34, s34, 15
    s_lshl_b32 s35, s35, 15
    buffer_load_dwordx4 v5, s[4:7], s34 offen nt lds
    s_add_u32 m0, s33, 4096
    s_nop 0
    buffer_load_dwordx4 v5, s[4:7], s35 offen nt lds
    s_add_u32 m0, s33, 8192
    s_nop 0
    buffer_load_dwordx4 v6, s[8:11], s34 offen nt lds
    s_add_u32 m0, s33, 12288
    s_nop 0
    buffer_load_dwordx4 v6, s[8:11], s35 offen nt lds
    s_add_u32 s32, s32, 1
    s_add_u32 s33, s33, 16384
    s_mov_b32 s56, 4294967295
L_p_nf:
    s_lshr_b32 s28, s61, 4
    s_sub_i32 s29, s28, 2
    v_cmp_gt_i32 s[76:77], s28, v10
    v_cmp_gt_i32 s[78:79], s29, v10
    v_lshlrev_b32 v16, 15, v20
    v_lshlrev_b32 v17, 15, v21
    v_lshlrev_b32 v18, 15, v22
    v_lshlrev_b32 v19, 15, v23
    v_cndmask_b32 v17, v11, v17, s[76:77]
    v_cndmask_b32 v19, v11, v19, s[78:79]
    v_lshlrev_b32 v8, 4, v1
    s_lshl_b32 s30, s60, 10
    s_add_u32 s54, s67, s71
    s_add_u32 s57, s54, s53
    s_lshl_b32 s58, s60, 3
    s_add_u32 s58, s58, s24
    s_lshl_b32 s58, s58, 14
    s_add_u32 s55, s73, 1
    s_mov_b32 s31, 1
    s_cmp_eq_u32 s53, 0
    s_cbranch_scc1 L_p_one
    buffer_load_dwordx4 v[20:23], v8, s[16:19], s30 offen
    s_add_u32 s55, s55, s53
    s_add_u32 s55, s55, 1
    s_mov_b32 s31, 2
    s_lshl_b32 s28, s57, 5
    s_sub_u32 s28, s62, s28
    s_add_u32 s28, s28, 33
    s_lshr_b32 s29, s75, s60
    s_and_b32 s29, s29, 1
    v_mov_b32 v32, s60
    v_mov_b32 v33, s53
    v_mov_b32 v34, s28
    v_mov_b32 v35, s29
    v_mov_b32 v9, 81952
    ds_write_b128 v9, v[32:35]
    s_cmp_ge_u32 s73, 4
    s_cbranch_scc1 L_p_one
    s_waitcnt vmcnt(0)
L_p_one:
    s_lshl_b32 s28, s52, 5
    s_sub_u32 s28, s61, s28
    s_add_u32 s28, s28, 33
    s_lshr_b32 s29, s75, s25
    s_and_b32 s29, s29, 1
    v_mov_b32 v28, s25
    v_mov_b32 v29, s73
    v_mov_b32 v30, s28
    v_mov_b32 v31, s29
    v_mov_b32 v24, s31
    v_mov_b32 v25, s74
    v_mov_b32 v26, s60
    v_mov_b32 v27, 0
    v_mov_b32 v9, 81920
    ds_write_b128 v9, v[24:27]
    ds_write_b128 v9, v[28:31] offset:16
    s_sub_u32 s65, s55, 11
    s_cmp_eq_u32 s27, 0
    s_cselect_b32 s65, 0x7fffffff, s65
    s_waitcnt lgkmcnt(0)
    s_cmp_eq_u32 s84, 1
    s_cbranch_scc1 L_p_loop_s
L_p_loop_o:
    s_cmp_eq_u32 s32, s52
    s_cbranch_scc1 L_p_sw_o
L_p_kv_o:
    s_lshr_b32 s28, s32, 1
    s_bitcmp1_b32 s32, 0
    s_cbranch_scc1 L_p_odd_o
    v_readlane_b32 s34, v16, s28
    v_readlane_b32 s35, v17, s28
L_p_rd_o:
    s_add_u32 s32, s32, 1
    s_mov_b32 m0, s33
    s_cmp_lt_i32 s56, 0
    s_waitcnt vmcnt(5)
    s_cbranch_scc1 L_p_nb_o
    s_barrier
L_p_nb_o:
    s_add_u32 s56, s56, 1
    s_cmp_eq_u32 s56, s55
    s_cbranch_scc1 L_p_done
    buffer_load_dwordx4 v5, s[4:7], s34 offen nt lds
    s_add_u32 m0, s33, 4096
    s_waitcnt vmcnt(5)
    buffer_load_dwordx4 v5, s[4:7], s35 offen nt lds
    s_add_u32 m0, s33, 8192
    s_waitcnt vmcnt(5)
    buffer_load_dwordx4 v6, s[8:11], s34 offen nt lds
    s_add_u32 m0, s33, 12288
    s_waitcnt vmcnt(4)
    buffer_load_dwordx4 v6, s[8:11], s35 offen nt lds
L_p_next_o:
    s_add_u32 s33, s33, 16384
    s_cmp_ge_u32 s33, 81920
    s_cselect_b32 s28, 81920, 0
    s_sub_u32 s33, s33, s28
    s_cmp_lt_i32 s56, s65
    s_cbranch_scc1 L_p_loop_o
    s_branch L_p_loop_b
L_p_odd_o:
    v_readlane_b32 s34, v18, s28
    v_readlane_b32 s35, v19, s28
    s_branch L_p_rd_o
L_p_sw_o:
    s_cmp_lg_u32 s53, 0
    s_cbranch_scc1 L_p_q_o
L_p_dum_o:
    v_mov_b32 v16, v11
    v_mov_b32 v17, v11
    v_mov_b32 v18, v11
    v_mov_b32 v19, v11
    s_mov_b32 s52, -1
    s_branch L_p_kv_o
L_p_q_o:
    s_mov_b32 m0, s33
    s_cmp_lt_i32 s56, 0
    s_waitcnt vmcnt(5)
    s_cbranch_scc1 L_p_qb_o
    s_barrier
L_p_qb_o:
    s_add_u32 s56, s56, 1
    s_mov_b32 s34, s58
    buffer_load_dwordx4 v7, s[12:15], s34 offen lds
    s_add_u32 m0, s33, 4096
    s_add_u32 s34, s34, 4096
    buffer_load_dwordx4 v7, s[12:15], s34 offen lds
    s_add_u32 m0, s33, 8192
    s_add_u32 s34, s34, 4096
    buffer_load_dwordx4 v7, s[12:15], s34 offen lds
    s_add_u32 m0, s33, 12288
    s_add_u32 s34, s34, 4096
    buffer_load_dwordx4 v7, s[12:15], s34 offen lds
    s_lshr_b32 s28, s62, 4
    s_sub_i32 s29, s28, 2
    v_cmp_gt_i32 s[76:77], s28, v10
    v_cmp_gt_i32 s[78:79], s29, v10
    v_lshlrev_b32 v16, 15, v20
    v_lshlrev_b32 v17, 15, v21
    v_lshlrev_b32 v18, 15, v22
    v_lshlrev_b32 v19, 15, v23
    v_cndmask_b32 v17, v11, v17, s[76:77]
    v_cndmask_b32 v19, v11, v19, s[78:79]
    s_mov_b32 s53, 0
    s_mov_b32 s32, s54
    s_mov_b32 s52, s57
    s_branch L_p_next_o
L_p_loop_b:
    s_cmp_eq_u32 s32, s52
    s_cbranch_scc1 L_p_sw_b
L_p_kv_b:
    s_lshr_b32 s28, s32, 1
    s_bitcmp1_b32 s32, 0
    s_cbranch_scc1 L_p_odd_b
    v_readlane_b32 s34, v16, s28
    v_readlane_b32 s35, v17, s28
L_p_rd_b:
    s_add_u32 s32, s32, 1
    s_mov_b32 m0, s33
    s_cmp_lt_i32 s56, 0
    s_waitcnt vmcnt(7)
    s_cbranch_scc1 L_p_nb_b
    s_barrier
L_p_nb_b:
    s_add_u32 s56, s56, 1
    s_cmp_eq_u32 s56, s55
    s_cbranch_scc1 L_p_done
    buffer_load_dwordx4 v5, s[4:7], s34 offen nt lds
    s_add_u32 m0, s33, 4096
    s_waitcnt vmcnt(7)
    buffer_load_dwordx4 v5, s[4:7], s35 offen nt lds
    s_add_u32 m0, s33, 8192
    s_waitcnt vmcnt(7)
    buffer_load_dwordx4 v6, s[8:11], s34 offen nt lds
    s_add_u32 m0, s33, 12288
    s_waitcnt vmcnt(7)
    buffer_load_dwordx4 v6, s[8:11], s35 offen nt lds
L_p_next_b:
    s_add_u32 s33, s33, 16384
    s_cmp_ge_u32 s33, 81920
    s_cselect_b32 s28, 81920, 0
    s_sub_u32 s33, s33, s28
    s_branch L_p_loop_b
L_p_odd_b:
    v_readlane_b32 s34, v18, s28
    v_readlane_b32 s35, v19, s28
    s_branch L_p_rd_b
L_p_sw_b:
    s_cmp_lg_u32 s53, 0
    s_cbranch_scc1 L_p_q_b
L_p_dum_b:
    v_mov_b32 v16, v11
    v_mov_b32 v17, v11
    v_mov_b32 v18, v11
    v_mov_b32 v19, v11
    s_mov_b32 s52, -1
    s_branch L_p_kv_b
L_p_q_b:
    s_mov_b32 m0, s33
    s_cmp_lt_i32 s56, 0
    s_waitcnt vmcnt(7)
    s_cbranch_scc1 L_p_qb_b
    s_barrier
L_p_qb_b:
    s_add_u32 s56, s56, 1
    s_mov_b32 s34, s58
    buffer_load_dwordx4 v7, s[12:15], s34 offen lds
    s_add_u32 m0, s33, 4096
    s_add_u32 s34, s34, 4096
    buffer_load_dwordx4 v7, s[12:15], s34 offen lds
    s_add_u32 m0, s33, 8192
    s_add_u32 s34, s34, 4096
    buffer_load_dwordx4 v7, s[12:15], s34 offen lds
    s_add_u32 m0, s33, 12288
    s_add_u32 s34, s34, 4096
    buffer_load_dwordx4 v7, s[12:15], s34 offen lds
    s_lshr_b32 s28, s62, 4
    s_sub_i32 s29, s28, 2
    v_cmp_gt_i32 s[76:77], s28, v10
    v_cmp_gt_i32 s[78:79], s29, v10
    v_lshlrev_b32 v16, 15, v20
    v_lshlrev_b32 v17, 15, v21
    v_lshlrev_b32 v18, 15, v22
    v_lshlrev_b32 v19, 15, v23
    v_cndmask_b32 v17, v11, v17, s[76:77]
    v_cndmask_b32 v19, v11, v19, s[78:79]
    s_mov_b32 s53, 0
    s_mov_b32 s32, s54
    s_mov_b32 s52, s57
    s_branch L_p_next_b
L_p_loop_s:
    s_cmp_eq_u32 s32, s52
    s_cbranch_scc1 L_p_sw_s
L_p_kv_s:
    s_lshr_b32 s28, s32, 1
    s_bitcmp1_b32 s32, 0
    s_cbranch_scc1 L_p_odd_s
    v_readlane_b32 s34, v16, s28
    v_readlane_b32 s35, v17, s28
L_p_rd_s:
    s_add_u32 s32, s32, 1
    s_mov_b32 m0, s33
    s_cmp_lt_i32 s56, 0
    s_waitcnt vmcnt(6)
    s_cbranch_scc1 L_p_nb_s
    s_barrier
L_p_nb_s:
    s_add_u32 s56, s56, 1
    s_cmp_eq_u32 s56, s55
    s_cbranch_scc1 L_p_done
    buffer_load_dwordx4 v5, s[4:7], s34 offen nt lds
    s_add_u32 m0, s33, 4096
    s_waitcnt vmcnt(5)
    buffer_load_dwordx4 v5, s[4:7], s35 offen nt lds
    s_add_u32 m0, s33, 8192
    s_waitcnt vmcnt(6)
    buffer_load_dwordx4 v6, s[8:11], s34 offen nt lds
    s_add_u32 m0, s33, 12288
    s_waitcnt vmcnt(5)
    buffer_load_dwordx4 v6, s[8:11], s35 offen nt lds
L_p_next_s:
    s_add_u32 s33, s33, 16384
    s_cmp_ge_u32 s33, 81920
    s_cselect_b32 s28, 81920, 0
    s_sub_u32 s33, s33, s28
    s_cmp_lt_i32 s56, s65
    s_cbranch_scc1 L_p_loop_s
    s_branch L_p_loop_b
L_p_odd_s:
    v_readlane_b32 s34, v18, s28
    v_readlane_b32 s35, v19, s28
    s_branch L_p_rd_s
L_p_sw_s:
    s_cmp_lg_u32 s53, 0
    s_cbranch_scc1 L_p_q_s
L_p_dum_s:
    v_mov_b32 v16, v11
    v_mov_b32 v17, v11
    v_mov_b32 v18, v11
    v_mov_b32 v19, v11
    s_mov_b32 s52, -1
    s_branch L_p_kv_s
L_p_q_s:
    s_mov_b32 m0, s33
    s_cmp_lt_i32 s56, 0
    s_waitcnt vmcnt(6)
    s_cbranch_scc1 L_p_qb_s
    s_barrier
L_p_qb_s:
    s_add_u32 s56, s56, 1
    s_mov_b32 s34, s58
    buffer_load_dwordx4 v7, s[12:15], s34 offen lds
    s_add_u32 m0, s33, 4096
    s_add_u32 s34, s34, 4096
    buffer_load_dwordx4 v7, s[12:15], s34 offen lds
    s_add_u32 m0, s33, 8192
    s_add_u32 s34, s34, 4096
    buffer_load_dwordx4 v7, s[12:15], s34 offen lds
    s_add_u32 m0, s33, 12288
    s_add_u32 s34, s34, 4096
    buffer_load_dwordx4 v7, s[12:15], s34 offen lds
    s_lshr_b32 s28, s62, 4
    s_sub_i32 s29, s28, 2
    v_cmp_gt_i32 s[76:77], s28, v10
    v_cmp_gt_i32 s[78:79], s29, v10
    v_lshlrev_b32 v16, 15, v20
    v_lshlrev_b32 v17, 15, v21
    v_lshlrev_b32 v18, 15, v22
    v_lshlrev_b32 v19, 15, v23
    v_cndmask_b32 v17, v11, v17, s[76:77]
    v_cndmask_b32 v19, v11, v19, s[78:79]
    s_mov_b32 s53, 0
    s_mov_b32 s32, s54
    s_mov_b32 s52, s57
    s_branch L_p_next_s
L_p_done:
    s_endpgm
L_consumer:
    v_lshrrev_b32 v3, 4, v1
    v_lshlrev_b32 v2, 2, v3
    v_and_b32 v199, 15, v1
    v_mul_u32_u24 v202, 18944, v199
    s_lshl_b32 s99, s25, 1
    s_lshl_b32 s28, s24, 7
    s_add_u32 s28, s28, s26
    s_mul_i32 s100, s28, 4736
    s_mul_i32 s72, s25, 37888
    s_add_u32 s72, s72, s100
    s_add_u32 s29, s72, 4608
    v_xor_b32 v4, v3, v199
    v_lshlrev_b32 v4, 4, v4
    v_lshl_add_u32 v4, v199, 8, v4
    v_xor_b32 v5, 64, v4
    v_xor_b32 v6, 0x80, v4
    v_xor_b32 v7, 0xc0, v4
    v_lshlrev_b32 v197, 8, v199
    v_lshl_add_u32 v197, v3, 4, v197
    s_waitcnt lgkmcnt(0)
    s_mov_b32 s4, s50
    s_and_b32 s5, s51, 0xffff
    s_mov_b32 s6, 0x4a0000
    s_mov_b32 s7, 0x20000
    v_add_u32 v202, s29, v202
    v_lshlrev_b32 v198, 4, v1
    v_lshlrev_b32 v201, 3, v1
    v_lshrrev_b32 v3, 2, v1
    v_and_b32 v199, 7, v3
    v_lshlrev_b32 v199, 5, v199
    v_lshl_add_u32 v8, v3, 8, v199
    v_and_b32 v199, 3, v1
    v_lshl_add_u32 v8, v199, 3, v8
    v_add_u32 v8, 0x2000, v8
    v_xor_b32 v9, 32, v8
    v_xor_b32 v10, 64, v8
    v_xor_b32 v11, 96, v8
    v_xor_b32 v12, 128, v8
    v_xor_b32 v13, 160, v8
    v_xor_b32 v14, 192, v8
    v_xor_b32 v15, 224, v8
    s_lshl_b32 s28, s24, 5
    v_mov_b32 v200, s28
    v_mov_b32 v209, 81920
    v_mov_b32 v195, 81920
    v_mov_b32 v208, 0xff800000
    v_mov_b32 v211, 0
    v_mov_b32 v203, 0
    s_mov_b32 s16, 0x3e0293ee
    s_mov_b32 s17, 0x40c00000
    s_mov_b32 s20, 0
    s_mov_b32 s101, 0
    s_mov_b32 s54, 16384
    s_mov_b32 s55, 0xffff0000
    s_mov_b32 s52, 0
    s_mov_b32 s80, 0
    s_mov_b32 s81, 0
    s_mov_b32 s75, 0
    s_mov_b32 s34, 0
    s_mov_b32 s35, 0
    v_mov_b32 v144, 0x3f803f80
    v_mov_b32 v145, 0x3f803f80
    v_mov_b32 v146, 0x3f803f80
    v_mov_b32 v147, 0x3f803f80
    v_mov_b32 v194, 0xff61b1e6
    s_mov_b32 s8, s46
    s_and_b32 s9, s47, 0xffff
    s_mov_b32 s10, 0x200000
    s_mov_b32 s11, 0x20000
    s_mov_b32 s12, s48
    s_and_b32 s13, s49, 0xffff
    s_mov_b32 s14, 0x100
    s_mov_b32 s15, 0x20000
    v_mov_b32 v176, v194
    v_mov_b32 v177, 0
    v_mov_b32 v232, v194
    v_mov_b32 v233, 0
    v_mov_b32 v250, v194
    v_mov_b32 v251, 0
    v_mov_b32 v108, 0
    v_mov_b32 v109, 0
    v_mov_b32 v110, 0
    v_mov_b32 v111, 0
    v_mov_b32 v112, 0
    v_mov_b32 v113, 0
    v_mov_b32 v114, 0
    v_mov_b32 v115, 0
    v_mov_b32 v116, 0
    v_mov_b32 v117, 0
    v_mov_b32 v118, 0
    v_mov_b32 v119, 0
    v_mov_b32 v120, 0
    v_mov_b32 v121, 0
    v_mov_b32 v122, 0
    v_mov_b32 v123, 0
    v_mov_b32 v124, 0
    v_mov_b32 v125, 0
    v_mov_b32 v126, 0
    v_mov_b32 v127, 0
    v_mov_b32 v128, 0
    v_mov_b32 v129, 0
    v_mov_b32 v130, 0
    v_mov_b32 v131, 0
    v_mov_b32 v132, 0
    v_mov_b32 v133, 0
    v_mov_b32 v134, 0
    v_mov_b32 v135, 0
    v_mov_b32 v136, 0
    v_mov_b32 v137, 0
    v_mov_b32 v138, 0
    v_mov_b32 v139, 0
    v_mov_b32 v140, 0
    v_mov_b32 v48, 0
    v_mov_b32 v49, 0
    v_mov_b32 v50, 0
    v_mov_b32 v51, 0
    v_mov_b32 v52, 0
    v_mov_b32 v53, 0
    v_mov_b32 v54, 0
    v_mov_b32 v55, 0
    v_mov_b32 v56, 0
    v_mov_b32 v57, 0
    v_mov_b32 v58, 0
    v_mov_b32 v59, 0
    v_mov_b32 v60, 0
    v_mov_b32 v61, 0
    v_mov_b32 v62, 0
    v_mov_b32 v63, 0
    v_mov_b32 v64, 0
    v_mov_b32 v65, 0
    v_mov_b32 v66, 0
    v_mov_b32 v67, 0
    v_mov_b32 v68, 0
    v_mov_b32 v69, 0
    v_mov_b32 v70, 0
    v_mov_b32 v71, 0
    v_mov_b32 v72, 0
    v_mov_b32 v73, 0
    v_mov_b32 v74, 0
    v_mov_b32 v75, 0
    v_mov_b32 v76, 0
    v_mov_b32 v77, 0
    v_mov_b32 v78, 0
    v_mov_b32 v79, 0
    v_mov_b32 v96, v208
    v_mov_b32 v97, v208
    v_mov_b32 v98, v208
    v_mov_b32 v99, v208
    v_mov_b32 v100, v208
    v_mov_b32 v101, v208
    v_mov_b32 v102, v208
    v_mov_b32 v103, v208
    v_mov_b32 v148, 0xff61b1e6
    s_mov_b64 exec, 3
    buffer_load_dword v210, v202, s[4:7], 0 offen sc1
    s_mov_b64 exec, -1
    s_waitcnt vmcnt(0)
    v_mov_b32 v203, 0
    v_mov_b32 v196, v210
    s_branch L_piece1
L_piece:
    v_mov_b32 v108, 0
    v_mov_b32 v109, 0
    v_mov_b32 v110, 0
    v_mov_b32 v111, 0
    v_mov_b32 v112, 0
    v_mov_b32 v113, 0
    v_mov_b32 v114, 0
    v_mov_b32 v115, 0
    v_mov_b32 v116, 0
    v_mov_b32 v117, 0
    v_mov_b32 v118, 0
    v_mov_b32 v119, 0
    v_mov_b32 v120, 0
    v_mov_b32 v121, 0
    v_mov_b32 v122, 0
    v_mov_b32 v123, 0
    v_mov_b32 v124, 0
    v_mov_b32 v125, 0
    v_mov_b32 v126, 0
    v_mov_b32 v127, 0
    v_mov_b32 v128, 0
    v_mov_b32 v129, 0
    v_mov_b32 v130, 0
    v_mov_b32 v131, 0
    v_mov_b32 v132, 0
    v_mov_b32 v133, 0
    v_mov_b32 v134, 0
    v_mov_b32 v135, 0
    v_mov_b32 v136, 0
    v_mov_b32 v137, 0
    v_mov_b32 v138, 0
    v_mov_b32 v139, 0
    v_mov_b32 v140, 0
    v_mov_b32 v48, 0
    v_mov_b32 v49, 0
    v_mov_b32 v50, 0
    v_mov_b32 v51, 0
    v_mov_b32 v52, 0
    v_mov_b32 v53, 0
    v_mov_b32 v54, 0
    v_mov_b32 v55, 0
    v_mov_b32 v56, 0
    v_mov_b32 v57, 0
    v_mov_b32 v58, 0
    v_mov_b32 v59, 0
    v_mov_b32 v60, 0
    v_mov_b32 v61, 0
    v_mov_b32 v62, 0
    v_mov_b32 v63, 0
    v_mov_b32 v64, 0
    v_mov_b32 v65, 0
    v_mov_b32 v66, 0
    v_mov_b32 v67, 0
    v_mov_b32 v68, 0
    v_mov_b32 v69, 0
    v_mov_b32 v70, 0
    v_mov_b32 v71, 0
    v_mov_b32 v72, 0
    v_mov_b32 v73, 0
    v_mov_b32 v74, 0
    v_mov_b32 v75, 0
    v_mov_b32 v76, 0
    v_mov_b32 v77, 0
    v_mov_b32 v78, 0
    v_mov_b32 v79, 0
    v_mov_b32 v96, v208
    v_mov_b32 v97, v208
    v_mov_b32 v98, v208
    v_mov_b32 v99, v208
    v_mov_b32 v100, v208
    v_mov_b32 v101, v208
    v_mov_b32 v102, v208
    v_mov_b32 v103, v208
    v_mov_b32 v148, 0xff61b1e6
L_piece1:
    s_lshl_b32 s28, s26, 12
    s_mov_b32 s89, 0
    v_add_u32 v150, s28, v4
    v_add_u32 v151, s28, v5
    v_add_u32 v152, s28, v6
    v_add_u32 v153, s28, v7
    s_add_u32 s20, s20, 1
    s_cmp_eq_u32 s20, 5
    s_cselect_b32 s20, 0, s20
    s_cselect_b32 s21, 0xffff0000, s54
    v_add_u32 v4, s21, v4
    v_add_u32 v5, s21, v5
    v_add_u32 v6, s21, v6
    v_add_u32 v7, s21, v7
    v_add_u32 v8, s21, v8
    v_add_u32 v9, s21, v9
    v_add_u32 v10, s21, v10
    v_add_u32 v11, s21, v11
    v_add_u32 v12, s21, v12
    v_add_u32 v13, s21, v13
    v_add_u32 v14, s21, v14
    v_add_u32 v15, s21, v15
    s_barrier
    ds_read_b128 v[180:183], v195
    ds_read_b128 v[204:207], v209 offset:16
    ds_read_b128 v[80:83], v150
    ds_read_b128 v[84:87], v151
    ds_read_b128 v[88:91], v152
    ds_read_b128 v[92:95], v153
    v_add_u32 v209, 16, v209
    s_waitcnt lgkmcnt(4)
    v_readfirstlane_b32 s22, v180
    v_readfirstlane_b32 s23, v181
    v_readfirstlane_b32 s32, v204
    v_readfirstlane_b32 s18, v205
    v_readfirstlane_b32 s33, v206
    v_readfirstlane_b32 s53, v207
    s_cmp_eq_u32 s52, 0
    s_cbranch_scc1 L_pc_home
    s_mul_i32 s28, s32, 37888
    s_add_u32 s28, s28, s100
    s_add_u32 s28, s28, 23552
    s_mov_b64 exec, 2
    v_mov_b32 v202, s28
    buffer_load_dword v210, v202, s[4:7], 0 offen sc1
    s_mov_b64 exec, -1
L_pc_home:
    s_cmp_lg_u32 s18, 0
    s_cbranch_scc1 L_pc_go
    s_mov_b32 s101, s20
    s_add_u32 s52, s52, 1
    s_cmp_lt_u32 s52, s22
    s_waitcnt lgkmcnt(0)
    s_cbranch_scc1 L_piece
    s_endpgm
L_pc_go:
    s_min_u32 s19, s18, 4
    s_cmp_eq_u32 s23, 0
    s_cselect_b32 s19, 0, s19
    s_cmp_eq_u32 s53, 0
    s_waitcnt lgkmcnt(0)
    s_cbranch_scc1 L_kv
    v_mov_b32 v80, 0
    v_mov_b32 v81, 0
    v_mov_b32 v82, 0
    v_mov_b32 v83, 0
    v_mov_b32 v84, 0
    v_mov_b32 v85, 0
    v_mov_b32 v86, 0
    v_mov_b32 v87, 0
    v_mov_b32 v88, 0
    v_mov_b32 v89, 0
    v_mov_b32 v90, 0
    v_mov_b32 v91, 0
    v_mov_b32 v92, 0
    v_mov_b32 v93, 0
    v_mov_b32 v94, 0
    v_mov_b32 v95, 0
L_kv:
    s_cmp_eq_u32 s18, s19
    s_cbranch_scc1 L_service
L_kvbar:
    s_barrier
L_body:
    ds_read_b128 v[16:19], v4
    v_max3_f32 v149, v96, v97, v98
    v_max3_f32 v158, v99, v100, v101
    ds_read_b128 v[32:35], v4 offset:4096
    v_max3_f32 v149, v149, v102, v103
    v_max_f32 v149, v149, v158
    ds_read_b128 v[20:23], v5
    v_fma_f32 v158, v149, s16, -v148
    v_cmp_lt_f32 vcc, s17, v158
    s_cbranch_vccnz L_rare
L_back:
    ds_read_b128 v[36:39], v5 offset:4096
    v_fma_f32 v150, v96, s16, -v148
    v_fma_f32 v151, v97, s16, -v148
    v_fma_f32 v152, v98, s16, -v148
    v_fma_f32 v153, v99, s16, -v148
    ds_read_b128 v[24:27], v6
    v_fma_f32 v154, v100, s16, -v148
    v_fma_f32 v155, v101, s16, -v148
    v_fma_f32 v156, v102, s16, -v148
    v_fma_f32 v157, v103, s16, -v148
    ds_read_b128 v[40:43], v6 offset:4096
    v_exp_f32 v150, v150
    v_exp_f32 v151, v151
    v_exp_f32 v152, v152
    ds_read_b128 v[28:31], v7
    v_exp_f32 v153, v153
    v_exp_f32 v154, v154
    v_exp_f32 v155, v155
    ds_read_b128 v[44:47], v7 offset:4096
    v_exp_f32 v156, v156
    v_exp_f32 v157, v157
    s_nop 0
    v_cvt_pk_bf16_f32 v104, v150, v151
    v_cvt_pk_bf16_f32 v105, v152, v153
    v_cvt_pk_bf16_f32 v106, v154, v155
    v_cvt_pk_bf16_f32 v107, v156, v157
    s_nop 0
    s_cmp_eq_u32 s18, 0
    v_mfma_f32_16x16x32_bf16 v[140:143], v[144:147], v[104:107], v[140:143]
    v_mfma_f32_16x16x32_bf16 v[108:111], v[48:51], v[104:107], v[108:111]
    ds_read_b64_tr_b16 v[48:49], v8
    ds_read_b64_tr_b16 v[50:51], v8 offset:4096
    v_mfma_f32_16x16x32_bf16 v[112:115], v[52:55], v[104:107], v[112:115]
    ds_read_b64_tr_b16 v[52:53], v9
    ds_read_b64_tr_b16 v[54:55], v9 offset:4096
    v_mfma_f32_16x16x32_bf16 v[116:119], v[56:59], v[104:107], v[116:119]
    ds_read_b64_tr_b16 v[56:57], v10
    ds_read_b64_tr_b16 v[58:59], v10 offset:4096
    v_mfma_f32_16x16x32_bf16 v[120:123], v[60:63], v[104:107], v[120:123]
    ds_read_b64_tr_b16 v[60:61], v11
    ds_read_b64_tr_b16 v[62:63], v11 offset:4096
    v_mfma_f32_16x16x32_bf16 v[124:127], v[64:67], v[104:107], v[124:127]
    ds_read_b64_tr_b16 v[64:65], v12
    ds_read_b64_tr_b16 v[66:67], v12 offset:4096
    v_mfma_f32_16x16x32_bf16 v[128:131], v[68:71], v[104:107], v[128:131]
    ds_read_b64_tr_b16 v[68:69], v13
    ds_read_b64_tr_b16 v[70:71], v13 offset:4096
    v_mfma_f32_16x16x32_bf16 v[132:135], v[72:75], v[104:107], v[132:135]
    ds_read_b64_tr_b16 v[72:73], v14
    ds_read_b64_tr_b16 v[74:75], v14 offset:4096
    v_mfma_f32_16x16x32_bf16 v[136:139], v[76:79], v[104:107], v[136:139]
    ds_read_b64_tr_b16 v[76:77], v15
    ds_read_b64_tr_b16 v[78:79], v15 offset:4096
    s_cbranch_scc1 L_fin
    s_add_u32 s20, s20, 1
    s_cmp_eq_u32 s20, 5
    s_cselect_b32 s20, 0, s20
    s_cselect_b32 s21, 0xffff0000, s54
    s_waitcnt lgkmcnt(15)
    v_mfma_f32_16x16x32_bf16 v[96:99], v[16:19], v[80:83], 0
    v_add_u32 v4, s21, v4
    v_add_u32 v5, s21, v5
    v_mfma_f32_16x16x32_bf16 v[100:103], v[32:35], v[80:83], 0
    v_add_u32 v6, s21, v6
    v_add_u32 v7, s21, v7
    v_mfma_f32_16x16x32_bf16 v[96:99], v[20:23], v[84:87], v[96:99]
    v_add_u32 v8, s21, v8
    v_add_u32 v9, s21, v9
    v_mfma_f32_16x16x32_bf16 v[100:103], v[36:39], v[84:87], v[100:103]
    v_add_u32 v10, s21, v10
    v_add_u32 v11, s21, v11
    v_mfma_f32_16x16x32_bf16 v[96:99], v[24:27], v[88:91], v[96:99]
    v_add_u32 v12, s21, v12
    v_add_u32 v13, s21, v13
    v_mfma_f32_16x16x32_bf16 v[100:103], v[40:43], v[88:91], v[100:103]
    v_add_u32 v14, s21, v14
    v_add_u32 v15, s21, v15
    v_mfma_f32_16x16x32_bf16 v[96:99], v[28:31], v[92:95], v[96:99]
    v_mfma_f32_16x16x32_bf16 v[100:103], v[44:47], v[92:95], v[100:103]
    s_waitcnt lgkmcnt(0)
    s_sub_u32 s18, s18, 1
    s_waitcnt lgkmcnt(0)
    s_cmp_lg_u32 s18, 0
    s_cbranch_scc1 L_kv
    s_mov_b32 s89, 2
    s_cmp_ge_i32 s33, 32
    s_nop 7
    s_cbranch_scc1 L_body
    s_sub_u32 s28, s33, 0
    v_cmp_gt_i32 s[56:57], s28, v2
    s_sub_u32 s28, s33, 1
    v_cmp_gt_i32 s[58:59], s28, v2
    s_sub_u32 s28, s33, 2
    v_cmp_gt_i32 s[60:61], s28, v2
    s_sub_u32 s28, s33, 3
    v_cmp_gt_i32 s[62:63], s28, v2
    s_sub_u32 s28, s33, 16
    v_cmp_gt_i32 s[64:65], s28, v2
    s_sub_u32 s28, s33, 17
    v_cmp_gt_i32 s[66:67], s28, v2
    s_sub_u32 s28, s33, 18
    v_cmp_gt_i32 s[68:69], s28, v2
    s_sub_u32 s28, s33, 19
    v_cmp_gt_i32 s[70:71], s28, v2
    s_nop 1
    v_cndmask_b32 v96, v208, v96, s[56:57]
    v_cndmask_b32 v97, v208, v97, s[58:59]
    v_cndmask_b32 v98, v208, v98, s[60:61]
    v_cndmask_b32 v99, v208, v99, s[62:63]
    v_cndmask_b32 v100, v208, v100, s[64:65]
    v_cndmask_b32 v101, v208, v101, s[66:67]
    v_cndmask_b32 v102, v208, v102, s[68:69]
    v_cndmask_b32 v103, v208, v103, s[70:71]
    s_branch L_body
L_rare:
    v_mov_b32 v158, v149
    s_nop 1
    v_permlane32_swap_b32 v149, v158
    s_nop 1
    v_max_f32 v149, v149, v158
    v_mov_b32 v158, v149
    s_nop 1
    v_permlane16_swap_b32 v149, v158
    s_nop 1
    v_max_f32 v149, v149, v158
    v_mul_f32 v149, s16, v149
    v_max_f32 v149, v149, v148
    v_sub_f32 v158, v148, v149
    v_exp_f32 v158, v158
    v_mov_b32 v148, v149
    s_nop 0
    v_mul_f32 v108, v158, v108
    v_mul_f32 v109, v158, v109
    v_mul_f32 v110, v158, v110
    v_mul_f32 v111, v158, v111
    v_mul_f32 v112, v158, v112
    v_mul_f32 v113, v158, v113
    v_mul_f32 v114, v158, v114
    v_mul_f32 v115, v158, v115
    v_mul_f32 v116, v158, v116
    v_mul_f32 v117, v158, v117
    v_mul_f32 v118, v158, v118
    v_mul_f32 v119, v158, v119
    v_mul_f32 v120, v158, v120
    v_mul_f32 v121, v158, v121
    v_mul_f32 v122, v158, v122
    v_mul_f32 v123, v158, v123
    v_mul_f32 v124, v158, v124
    v_mul_f32 v125, v158, v125
    v_mul_f32 v126, v158, v126
    v_mul_f32 v127, v158, v127
    v_mul_f32 v128, v158, v128
    v_mul_f32 v129, v158, v129
    v_mul_f32 v130, v158, v130
    v_mul_f32 v131, v158, v131
    v_mul_f32 v132, v158, v132
    v_mul_f32 v133, v158, v133
    v_mul_f32 v134, v158, v134
    v_mul_f32 v135, v158, v135
    v_mul_f32 v136, v158, v136
    v_mul_f32 v137, v158, v137
    v_mul_f32 v138, v158, v138
    v_mul_f32 v139, v158, v139
    v_mul_f32 v140, v158, v140
    s_branch L_back
L_service:
    s_mov_b32 s31, 0
L_service2:
    s_waitcnt vmcnt(0)
    v_cmp_ne_u32 s[76:77], v196, v210
    v_readfirstlane_b32 s30, v203
    s_cmp_gt_u32 s18, 0
    s_cbranch_scc1 L_sv_nofold
    s_cmp_eq_u32 s80, 0
    s_cbranch_scc1 L_sv_nofold
L_merge:
    v_max3_f32 v149, v148, v176, v232
    s_or_b32 s34, s34, s35
    v_max_f32 v149, v149, v250
    s_mov_b32 s35, 0
    v_sub_f32 v180, v148, v149
    v_sub_f32 v182, v176, v149
    v_sub_f32 v184, v232, v149
    v_sub_f32 v186, v250, v149
    v_exp_f32 v180, v180
    v_exp_f32 v182, v182
    v_exp_f32 v184, v184
    v_exp_f32 v186, v186
    v_mov_b32 v148, v149
    v_mul_f32 v140, v140, v180
    v_fmac_f32 v140, v182, v177
    v_fmac_f32 v140, v184, v233
    v_fmac_f32 v140, v186, v251
    s_cmp_eq_u32 s34, s23
    s_cselect_b32 s88, s31, 0
    s_cmp_eq_u32 s88, 0
    s_cbranch_scc1 L_mg_scaled
    v_rcp_f32 v149, v140
    s_lshl_b32 s28, s25, 3
    s_add_u32 s28, s28, s24
    v_mul_f32 v180, v180, v149
    v_mul_f32 v182, v182, v149
    v_mul_f32 v184, v184, v149
    v_mul_f32 v186, v186, v149
    s_lshl_b32 s28, s28, 2
    s_add_u32 s28, s28, s26
    s_lshl_b32 s83, s28, 12
L_mg_scaled:
    v_pk_mul_f32 v[108:109], v[108:109], v[180:181] op_sel_hi:[1,0]
    v_pk_mul_f32 v[110:111], v[110:111], v[180:181] op_sel_hi:[1,0]
    v_pk_mul_f32 v[112:113], v[112:113], v[180:181] op_sel_hi:[1,0]
    v_pk_mul_f32 v[114:115], v[114:115], v[180:181] op_sel_hi:[1,0]
    v_pk_mul_f32 v[116:117], v[116:117], v[180:181] op_sel_hi:[1,0]
    v_pk_mul_f32 v[118:119], v[118:119], v[180:181] op_sel_hi:[1,0]
    v_pk_mul_f32 v[120:121], v[120:121], v[180:181] op_sel_hi:[1,0]
    v_pk_mul_f32 v[122:123], v[122:123], v[180:181] op_sel_hi:[1,0]
    v_pk_mul_f32 v[124:125], v[124:125], v[180:181] op_sel_hi:[1,0]
    v_pk_mul_f32 v[126:127], v[126:127], v[180:181] op_sel_hi:[1,0]
    v_pk_mul_f32 v[128:129], v[128:129], v[180:181] op_sel_hi:[1,0]
    v_pk_mul_f32 v[130:131], v[130:131], v[180:181] op_sel_hi:[1,0]
    v_pk_mul_f32 v[132:133], v[132:133], v[180:181] op_sel_hi:[1,0]
    v_pk_mul_f32 v[134:135], v[134:135], v[180:181] op_sel_hi:[1,0]
    v_pk_mul_f32 v[136:137], v[136:137], v[180:181] op_sel_hi:[1,0]
    v_pk_mul_f32 v[138:139], v[138:139], v[180:181] op_sel_hi:[1,0]
    s_cmp_le_u32 s80, 0
    s_cbranch_scc1 L_mg_done
L_mg_b0:
    v_lshlrev_b32 v150, 16, v160
    v_and_b32 v151, s55, v160
    v_pk_fma_f32 v[108:109], v[150:151], v[182:183], v[108:109] op_sel_hi:[1,0,1]
    v_lshlrev_b32 v152, 16, v161
    v_and_b32 v153, s55, v161
    v_pk_fma_f32 v[110:111], v[152:153], v[182:183], v[110:111] op_sel_hi:[1,0,1]
    v_lshlrev_b32 v154, 16, v162
    v_and_b32 v155, s55, v162
    v_pk_fma_f32 v[112:113], v[154:155], v[182:183], v[112:113] op_sel_hi:[1,0,1]
    v_lshlrev_b32 v156, 16, v163
    v_and_b32 v157, s55, v163
    v_pk_fma_f32 v[114:115], v[156:157], v[182:183], v[114:115] op_sel_hi:[1,0,1]
    v_lshlrev_b32 v150, 16, v164
    v_and_b32 v151, s55, v164
    v_pk_fma_f32 v[116:117], v[150:151], v[182:183], v[116:117] op_sel_hi:[1,0,1]
    v_lshlrev_b32 v152, 16, v165
    v_and_b32 v153, s55, v165
    v_pk_fma_f32 v[118:119], v[152:153], v[182:183], v[118:119] op_sel_hi:[1,0,1]
    v_lshlrev_b32 v154, 16, v166
    v_and_b32 v155, s55, v166
    v_pk_fma_f32 v[120:121], v[154:155], v[182:183], v[120:121] op_sel_hi:[1,0,1]
    v_lshlrev_b32 v156, 16, v167
    v_and_b32 v157, s55, v167
    v_pk_fma_f32 v[122:123], v[156:157], v[182:183], v[122:123] op_sel_hi:[1,0,1]
    v_lshlrev_b32 v150, 16, v168
    v_and_b32 v151, s55, v168
    v_pk_fma_f32 v[124:125], v[150:151], v[182:183], v[124:125] op_sel_hi:[1,0,1]
    v_lshlrev_b32 v152, 16, v169
    v_and_b32 v153, s55, v169
    v_pk_fma_f32 v[126:127], v[152:153], v[182:183], v[126:127] op_sel_hi:[1,0,1]
    v_lshlrev_b32 v154, 16, v170
    v_and_b32 v155, s55, v170
    v_pk_fma_f32 v[128:129], v[154:155], v[182:183], v[128:129] op_sel_hi:[1,0,1]
    v_lshlrev_b32 v156, 16, v171
    v_and_b32 v157, s55, v171
    v_pk_fma_f32 v[130:131], v[156:157], v[182:183], v[130:131] op_sel_hi:[1,0,1]
    v_lshlrev_b32 v150, 16, v172
    v_and_b32 v151, s55, v172
    v_pk_fma_f32 v[132:133], v[150:151], v[182:183], v[132:133] op_sel_hi:[1,0,1]
    v_lshlrev_b32 v152, 16, v173
    v_and_b32 v153, s55, v173
    v_pk_fma_f32 v[134:135], v[152:153], v[182:183], v[134:135] op_sel_hi:[1,0,1]
    v_lshlrev_b32 v154, 16, v174
    v_and_b32 v155, s55, v174
    v_pk_fma_f32 v[136:137], v[154:155], v[182:183], v[136:137] op_sel_hi:[1,0,1]
    v_lshlrev_b32 v156, 16, v175
    v_and_b32 v157, s55, v175
    v_pk_fma_f32 v[138:139], v[156:157], v[182:183], v[138:139] op_sel_hi:[1,0,1]
    s_cmp_le_u32 s80, 1
    s_cbranch_scc1 L_mg_done
L_mg_b1:
    v_lshlrev_b32 v150, 16, v216
    v_and_b32 v151, s55, v216
    v_pk_fma_f32 v[108:109], v[150:151], v[184:185], v[108:109] op_sel_hi:[1,0,1]
    v_lshlrev_b32 v152, 16, v217
    v_and_b32 v153, s55, v217
    v_pk_fma_f32 v[110:111], v[152:153], v[184:185], v[110:111] op_sel_hi:[1,0,1]
    v_lshlrev_b32 v154, 16, v218
    v_and_b32 v155, s55, v218
    v_pk_fma_f32 v[112:113], v[154:155], v[184:185], v[112:113] op_sel_hi:[1,0,1]
    v_lshlrev_b32 v156, 16, v219
    v_and_b32 v157, s55, v219
    v_pk_fma_f32 v[114:115], v[156:157], v[184:185], v[114:115] op_sel_hi:[1,0,1]
    v_lshlrev_b32 v150, 16, v220
    v_and_b32 v151, s55, v220
    v_pk_fma_f32 v[116:117], v[150:151], v[184:185], v[116:117] op_sel_hi:[1,0,1]
    v_lshlrev_b32 v152, 16, v221
    v_and_b32 v153, s55, v221
    v_pk_fma_f32 v[118:119], v[152:153], v[184:185], v[118:119] op_sel_hi:[1,0,1]
    v_lshlrev_b32 v154, 16, v222
    v_and_b32 v155, s55, v222
    v_pk_fma_f32 v[120:121], v[154:155], v[184:185], v[120:121] op_sel_hi:[1,0,1]
    v_lshlrev_b32 v156, 16, v223
    v_and_b32 v157, s55, v223
    v_pk_fma_f32 v[122:123], v[156:157], v[184:185], v[122:123] op_sel_hi:[1,0,1]
    v_lshlrev_b32 v150, 16, v224
    v_and_b32 v151, s55, v224
    v_pk_fma_f32 v[124:125], v[150:151], v[184:185], v[124:125] op_sel_hi:[1,0,1]
    v_lshlrev_b32 v152, 16, v225
    v_and_b32 v153, s55, v225
    v_pk_fma_f32 v[126:127], v[152:153], v[184:185], v[126:127] op_sel_hi:[1,0,1]
    v_lshlrev_b32 v154, 16, v226
    v_and_b32 v155, s55, v226
    v_pk_fma_f32 v[128:129], v[154:155], v[184:185], v[128:129] op_sel_hi:[1,0,1]
    v_lshlrev_b32 v156, 16, v227
    v_and_b32 v157, s55, v227
    v_pk_fma_f32 v[130:131], v[156:157], v[184:185], v[130:131] op_sel_hi:[1,0,1]
    v_lshlrev_b32 v150, 16, v228
    v_and_b32 v151, s55, v228
    v_pk_fma_f32 v[132:133], v[150:151], v[184:185], v[132:133] op_sel_hi:[1,0,1]
    v_lshlrev_b32 v152, 16, v229
    v_and_b32 v153, s55, v229
    v_pk_fma_f32 v[134:135], v[152:153], v[184:185], v[134:135] op_sel_hi:[1,0,1]
    v_lshlrev_b32 v154, 16, v230
    v_and_b32 v155, s55, v230
    v_pk_fma_f32 v[136:137], v[154:155], v[184:185], v[136:137] op_sel_hi:[1,0,1]
    v_lshlrev_b32 v156, 16, v231
    v_and_b32 v157, s55, v231
    v_pk_fma_f32 v[138:139], v[156:157], v[184:185], v[138:139] op_sel_hi:[1,0,1]
    s_cmp_le_u32 s80, 2
    s_cbranch_scc1 L_mg_done
L_mg_b2:
    v_lshlrev_b32 v150, 16, v234
    v_and_b32 v151, s55, v234
    v_pk_fma_f32 v[108:109], v[150:151], v[186:187], v[108:109] op_sel_hi:[1,0,1]
    v_lshlrev_b32 v152, 16, v235
    v_and_b32 v153, s55, v235
    v_pk_fma_f32 v[110:111], v[152:153], v[186:187], v[110:111] op_sel_hi:[1,0,1]
    v_lshlrev_b32 v154, 16, v236
    v_and_b32 v155, s55, v236
    v_pk_fma_f32 v[112:113], v[154:155], v[186:187], v[112:113] op_sel_hi:[1,0,1]
    v_lshlrev_b32 v156, 16, v237
    v_and_b32 v157, s55, v237
    v_pk_fma_f32 v[114:115], v[156:157], v[186:187], v[114:115] op_sel_hi:[1,0,1]
    v_lshlrev_b32 v150, 16, v238
    v_and_b32 v151, s55, v238
    v_pk_fma_f32 v[116:117], v[150:151], v[186:187], v[116:117] op_sel_hi:[1,0,1]
    v_lshlrev_b32 v152, 16, v239
    v_and_b32 v153, s55, v239
    v_pk_fma_f32 v[118:119], v[152:153], v[186:187], v[118:119] op_sel_hi:[1,0,1]
    v_lshlrev_b32 v154, 16, v240
    v_and_b32 v155, s55, v240
    v_pk_fma_f32 v[120:121], v[154:155], v[186:187], v[120:121] op_sel_hi:[1,0,1]
    v_lshlrev_b32 v156, 16, v241
    v_and_b32 v157, s55, v241
    v_pk_fma_f32 v[122:123], v[156:157], v[186:187], v[122:123] op_sel_hi:[1,0,1]
    v_lshlrev_b32 v150, 16, v242
    v_and_b32 v151, s55, v242
    v_pk_fma_f32 v[124:125], v[150:151], v[186:187], v[124:125] op_sel_hi:[1,0,1]
    v_lshlrev_b32 v152, 16, v243
    v_and_b32 v153, s55, v243
    v_pk_fma_f32 v[126:127], v[152:153], v[186:187], v[126:127] op_sel_hi:[1,0,1]
    v_lshlrev_b32 v154, 16, v244
    v_and_b32 v155, s55, v244
    v_pk_fma_f32 v[128:129], v[154:155], v[186:187], v[128:129] op_sel_hi:[1,0,1]
    v_lshlrev_b32 v156, 16, v245
    v_and_b32 v157, s55, v245
    v_pk_fma_f32 v[130:131], v[156:157], v[186:187], v[130:131] op_sel_hi:[1,0,1]
    v_lshlrev_b32 v150, 16, v246
    v_and_b32 v151, s55, v246
    v_pk_fma_f32 v[132:133], v[150:151], v[186:187], v[132:133] op_sel_hi:[1,0,1]
    v_lshlrev_b32 v152, 16, v247
    v_and_b32 v153, s55, v247
    v_pk_fma_f32 v[134:135], v[152:153], v[186:187], v[134:135] op_sel_hi:[1,0,1]
    v_lshlrev_b32 v154, 16, v248
    v_and_b32 v155, s55, v248
    v_pk_fma_f32 v[136:137], v[154:155], v[186:187], v[136:137] op_sel_hi:[1,0,1]
    v_lshlrev_b32 v156, 16, v249
    v_and_b32 v157, s55, v249
    v_pk_fma_f32 v[138:139], v[156:157], v[186:187], v[138:139] op_sel_hi:[1,0,1]
L_mg_done:
    s_cmp_lg_u32 s88, 0
    s_cbranch_scc1 L_out
    s_mov_b32 s80, 0
    v_mov_b32 v176, v194
    v_mov_b32 v232, v194
    v_mov_b32 v250, v194
    v_mov_b32 v177, 0
    v_mov_b32 v233, 0
    v_mov_b32 v251, 0
L_sv_nofold:
    s_lshr_b32 s28, s30, s99
    s_or_b32 s28, s28, s76
    s_and_b32 s28, s28, s23
    s_andn2_b32 s28, s28, s34
    s_andn2_b32 s74, s28, s35
    s_cmp_eq_u32 s80, 1
    s_cbranch_scc1 L_sv_ld1
    s_cmp_eq_u32 s80, 2
    s_cbranch_scc1 L_sv_ld2
    s_cmp_eq_u32 s80, 3
    s_cbranch_scc1 L_sv_noload
L_sv_ld0:
    s_cmp_eq_u32 s74, 0
    s_cbranch_scc1 L_sv_noload
    s_ff1_i32_b32 s29, s74
    s_bitset1_b32 s35, s29
    s_bitset0_b32 s74, s29
    s_mul_i32 s29, s29, 18944
    s_add_u32 s29, s29, s72
    s_add_u32 s30, s29, 4096
    s_mov_b32 s80, 1
    buffer_load_dwordx4 v[160:163], v198, s[4:7], s29 offen offset:0 sc1
    buffer_load_dwordx4 v[164:167], v198, s[4:7], s29 offen offset:1024 sc1
    buffer_load_dwordx4 v[168:171], v198, s[4:7], s29 offen offset:2048 sc1
    buffer_load_dwordx4 v[172:175], v198, s[4:7], s29 offen offset:3072 sc1
    buffer_load_dwordx2 v[176:177], v201, s[4:7], s30 offen sc1
L_sv_ld1:
    s_cmp_eq_u32 s74, 0
    s_cbranch_scc1 L_sv_noload
    s_ff1_i32_b32 s29, s74
    s_bitset1_b32 s35, s29
    s_bitset0_b32 s74, s29
    s_mul_i32 s29, s29, 18944
    s_add_u32 s29, s29, s72
    s_add_u32 s30, s29, 4096
    s_mov_b32 s80, 2
    buffer_load_dwordx4 v[216:219], v198, s[4:7], s29 offen offset:0 sc1
    buffer_load_dwordx4 v[220:223], v198, s[4:7], s29 offen offset:1024 sc1
    buffer_load_dwordx4 v[224:227], v198, s[4:7], s29 offen offset:2048 sc1
    buffer_load_dwordx4 v[228:231], v198, s[4:7], s29 offen offset:3072 sc1
    buffer_load_dwordx2 v[232:233], v201, s[4:7], s30 offen sc1
L_sv_ld2:
    s_cmp_eq_u32 s74, 0
    s_cbranch_scc1 L_sv_noload
    s_ff1_i32_b32 s29, s74
    s_bitset1_b32 s35, s29
    s_bitset0_b32 s74, s29
    s_mul_i32 s29, s29, 18944
    s_add_u32 s29, s29, s72
    s_add_u32 s30, s29, 4096
    s_mov_b32 s80, 3
    buffer_load_dwordx4 v[234:237], v198, s[4:7], s29 offen offset:0 sc1
    buffer_load_dwordx4 v[238:241], v198, s[4:7], s29 offen offset:1024 sc1
    buffer_load_dwordx4 v[242:245], v198, s[4:7], s29 offen offset:2048 sc1
    buffer_load_dwordx4 v[246:249], v198, s[4:7], s29 offen offset:3072 sc1
    buffer_load_dwordx2 v[250:251], v201, s[4:7], s30 offen sc1
L_sv_noload:
    s_or_b32 s28, s34, s35
    s_cmp_eq_u32 s28, s23
    s_cbranch_scc1 L_sv_ret
    s_andn2_b32 exec_lo, s23, s28
    s_mov_b32 exec_hi, 0
    buffer_load_dword v196, v202, s[4:7], 0 offen sc1
    s_mov_b64 exec, -1
    s_and_b32 s28, s31, 7
    s_cmp_lg_u32 s28, 7
    s_cbranch_scc1 L_sv_ret
    buffer_load_dword v203, v200, s[12:15], 0 offen sc1
L_sv_ret:
    s_cmp_gt_u32 s18, 0
    s_cselect_b32 s28, 2, 2
    s_sub_i32 s19, s18, s28
    s_max_i32 s19, s19, 0
    s_cmp_eq_u32 s34, s23
    s_cselect_b32 s19, 0, s19
    s_cmp_eq_u32 s31, 0
    s_cbranch_scc1 L_kvbar
L_own_wait:
    s_add_u32 s31, s31, 1
    s_cmp_lt_u32 s31, 0x8000
    s_cbranch_scc1 L_service2
    s_mov_b32 s23, s34
    s_mov_b32 s35, 0
    s_branch L_merge
L_fin:
    s_mov_b32 s31, 1
    s_mov_b32 s18, 0
    s_cmp_eq_u32 s27, 0
    s_nop 6
    s_cbranch_scc1 L_publish
    s_cmp_eq_u32 s23, s34
    s_cbranch_scc1 L_merge
    s_branch L_service2
L_out:
    v_cvt_pk_bf16_f32 v160, v108, v109
    v_cvt_pk_bf16_f32 v161, v110, v111
    v_cvt_pk_bf16_f32 v162, v112, v113
    v_cvt_pk_bf16_f32 v163, v114, v115
    v_cvt_pk_bf16_f32 v164, v116, v117
    v_cvt_pk_bf16_f32 v165, v118, v119
    v_cvt_pk_bf16_f32 v166, v120, v121
    v_cvt_pk_bf16_f32 v167, v122, v123
    v_cvt_pk_bf16_f32 v168, v124, v125
    v_cvt_pk_bf16_f32 v169, v126, v127
    v_cvt_pk_bf16_f32 v170, v128, v129
    v_cvt_pk_bf16_f32 v171, v130, v131
    v_cvt_pk_bf16_f32 v172, v132, v133
    v_cvt_pk_bf16_f32 v173, v134, v135
    v_cvt_pk_bf16_f32 v174, v136, v137
    v_cvt_pk_bf16_f32 v175, v138, v139
    v_permlane32_swap_b32 v160, v162
    v_permlane32_swap_b32 v161, v163
    v_permlane32_swap_b32 v164, v166
    v_permlane32_swap_b32 v165, v167
    v_permlane32_swap_b32 v168, v170
    v_permlane32_swap_b32 v169, v171
    v_permlane32_swap_b32 v172, v174
    v_permlane32_swap_b32 v173, v175
    s_nop 1
    v_permlane16_swap_b32 v160, v162
    v_permlane16_swap_b32 v161, v163
    v_permlane16_swap_b32 v164, v166
    v_permlane16_swap_b32 v165, v167
    v_permlane16_swap_b32 v168, v170
    v_permlane16_swap_b32 v169, v171
    v_permlane16_swap_b32 v172, v174
    v_permlane16_swap_b32 v173, v175
    s_nop 1
    buffer_store_dwordx4 v[160:163], v197, s[8:11], s83 offen offset:0
    buffer_store_dwordx4 v[164:167], v197, s[8:11], s83 offen offset:64
    buffer_store_dwordx4 v[168:171], v197, s[8:11], s83 offen offset:128
    buffer_store_dwordx4 v[172:175], v197, s[8:11], s83 offen offset:192
    s_endpgm
L_publish:
    v_cvt_pk_bf16_f32 v160, v108, v109
    v_cvt_pk_bf16_f32 v161, v110, v111
    v_cvt_pk_bf16_f32 v162, v112, v113
    v_cvt_pk_bf16_f32 v163, v114, v115
    v_cvt_pk_bf16_f32 v164, v116, v117
    v_cvt_pk_bf16_f32 v165, v118, v119
    v_cvt_pk_bf16_f32 v166, v120, v121
    v_cvt_pk_bf16_f32 v167, v122, v123
    v_cvt_pk_bf16_f32 v168, v124, v125
    v_cvt_pk_bf16_f32 v169, v126, v127
    v_cvt_pk_bf16_f32 v170, v128, v129
    v_cvt_pk_bf16_f32 v171, v130, v131
    v_cvt_pk_bf16_f32 v172, v132, v133
    v_cvt_pk_bf16_f32 v173, v134, v135
    v_cvt_pk_bf16_f32 v174, v136, v137
    v_cvt_pk_bf16_f32 v175, v138, v139
    v_mov_b32 v176, v148
    v_mov_b32 v177, v140
    s_lshl_b32 s28, s32, 1
    s_add_u32 s28, s28, s52
    s_mul_i32 s29, s28, 18944
    s_add_u32 s29, s29, s100
    s_bitset1_b32 s75, s28
    s_bitset1_b32 s81, s52
    s_add_u32 s52, s52, 1
    s_cmp_ge_u32 s52, s22
    s_cbranch_scc1 L_pub_now
    s_cmp_ge_u32 s80, 2
    s_cbranch_scc1 L_pub_now
    s_add_u32 s80, s80, 1
    s_mov_b32 s79, s78
    s_mov_b32 s78, s29
    v_mov_b32 v234, v216
    v_mov_b32 v216, v160
    v_mov_b32 v235, v217
    v_mov_b32 v217, v161
    v_mov_b32 v236, v218
    v_mov_b32 v218, v162
    v_mov_b32 v237, v219
    v_mov_b32 v219, v163
    v_mov_b32 v238, v220
    v_mov_b32 v220, v164
    v_mov_b32 v239, v221
    v_mov_b32 v221, v165
    v_mov_b32 v240, v222
    v_mov_b32 v222, v166
    v_mov_b32 v241, v223
    v_mov_b32 v223, v167
    v_mov_b32 v242, v224
    v_mov_b32 v224, v168
    v_mov_b32 v243, v225
    v_mov_b32 v225, v169
    v_mov_b32 v244, v226
    v_mov_b32 v226, v170
    v_mov_b32 v245, v227
    v_mov_b32 v227, v171
    v_mov_b32 v246, v228
    v_mov_b32 v228, v172
    v_mov_b32 v247, v229
    v_mov_b32 v229, v173
    v_mov_b32 v248, v230
    v_mov_b32 v230, v174
    v_mov_b32 v249, v231
    v_mov_b32 v231, v175
    v_mov_b32 v250, v232
    v_mov_b32 v232, v176
    v_mov_b32 v251, v233
    v_mov_b32 v233, v177
    s_waitcnt lgkmcnt(0)
    s_branch L_piece
L_pub_now:
    s_add_u32 s30, s29, 4096
    buffer_store_dwordx4 v[160:163], v198, s[4:7], s29 offen offset:0 sc1
    buffer_store_dwordx4 v[164:167], v198, s[4:7], s29 offen offset:1024 sc1
    buffer_store_dwordx4 v[168:171], v198, s[4:7], s29 offen offset:2048 sc1
    buffer_store_dwordx4 v[172:175], v198, s[4:7], s29 offen offset:3072 sc1
    buffer_store_dwordx2 v[176:177], v201, s[4:7], s30 offen sc1
    s_cmp_eq_u32 s80, 0
    s_cbranch_scc1 L_pub_flag
    s_add_u32 s30, s78, 4096
    buffer_store_dwordx4 v[216:219], v198, s[4:7], s78 offen offset:0 sc1
    buffer_store_dwordx4 v[220:223], v198, s[4:7], s78 offen offset:1024 sc1
    buffer_store_dwordx4 v[224:227], v198, s[4:7], s78 offen offset:2048 sc1
    buffer_store_dwordx4 v[228:231], v198, s[4:7], s78 offen offset:3072 sc1
    buffer_store_dwordx2 v[232:233], v201, s[4:7], s30 offen sc1
    s_cmp_eq_u32 s80, 1
    s_cbranch_scc1 L_pub_flag
    s_add_u32 s30, s79, 4096
    buffer_store_dwordx4 v[234:237], v198, s[4:7], s79 offen offset:0 sc1
    buffer_store_dwordx4 v[238:241], v198, s[4:7], s79 offen offset:1024 sc1
    buffer_store_dwordx4 v[242:245], v198, s[4:7], s79 offen offset:2048 sc1
    buffer_store_dwordx4 v[246:249], v198, s[4:7], s79 offen offset:3072 sc1
    buffer_store_dwordx2 v[250:251], v201, s[4:7], s30 offen sc1
L_pub_flag:
    v_mov_b32 v158, s75
    s_mov_b32 s80, 0
    s_waitcnt vmcnt(0) lgkmcnt(0)
    v_add_u32 v149, 1, v210
    s_mov_b32 exec_hi, 0
    s_mov_b32 exec_lo, s81
    buffer_store_dword v149, v202, s[4:7], 0 offen sc1
    s_mov_b64 exec, -1
    s_mov_b32 s81, 0
    s_cmp_lt_u32 s52, s22
    s_cbranch_scc1 L_piece
    s_barrier
    s_cmp_lg_u32 s26, 0
    s_cbranch_scc1 L_end
    s_mov_b64 exec, 1
    buffer_atomic_add v158, v200, s[12:15], 0 offen sc1
L_end:
    s_endpgm
.section .rodata,"a"
.p2align 6
.amdhsa_kernel standalone__paged_block_table_kv_pagedattention__sampling_kernel
.amdhsa_next_free_vgpr 256
.amdhsa_next_free_sgpr 102
.amdhsa_accum_offset 256
.amdhsa_group_segment_fixed_size 0
.amdhsa_kernarg_size 64
.amdhsa_user_sgpr_count 2
.amdhsa_user_sgpr_kernarg_segment_ptr 1
.amdhsa_system_sgpr_workgroup_id_x 1
.end_amdhsa_kernel
```
